```python
import torch

def _softmax(x, axis=-1):
    return torch.softmax(x, dim=axis)
def _gelu(x):
    return torch.nn.functional.gelu(x, approximate="tanh")
def _silu(x):
    return torch.nn.functional.silu(x)
def _sigmoid(x):
    return torch.sigmoid(x)
def _layernorm(x, axis=-1, eps=1e-5):
    m = x.mean(dim=axis, keepdim=True)
    v = x.var(dim=axis, keepdim=True, unbiased=False)
    return (x - m) / torch.sqrt(v + eps)
def _scatter_add(tgt, idx, src, axis=0):
    return tgt.clone().index_add_(axis, idx, src)
def _segment_sum(src, seg, n):
    out = torch.zeros((n,) + src.shape[1:], dtype=src.dtype)
    return out.index_add_(0, seg, src)
def _pad(x, pw):
    flat = tuple(v for pair in reversed(pw) for v in pair)
    return torch.nn.functional.pad(x, flat)

kernel_name = 'standalone__grouped__vision'

def setup_inputs():

    _w = (lambda a: (lambda t: t.to(torch.bfloat16) if t.is_floating_point() else t)(torch.as_tensor(a)))
    H = W = 224
    G = 4
    Cg = max(96 // G, 2)
    C = G * Cg
    k = 5
    scale = 1.0 / (k * Cg ** 0.5)
    return {
        "x": _w((lambda *s: torch.randn(*s, dtype=torch.bfloat16) * 0.05)(1, H, W, C)),
        "w": _w((lambda *s: torch.randn(*s, dtype=torch.bfloat16) * 0.05)(k, k, G, Cg, Cg) * scale),
    }

def reference(x, w):
    B, H, W, C = x.shape
    k = w.shape[0]
    G = w.shape[2]
    Cg = C // G
    pad = k // 2
    xp = _pad(x, ((0,0),(pad,pad),(pad,pad),(0,0)))
    xg = xp.reshape(B, H + 2 * pad, W + 2 * pad, G, Cg)
    out = torch.zeros_like(x).reshape(B, H, W, G, Cg)
    for i in range(k):
        for j in range(k):
            out = out + torch.einsum('bhwgc,gcd->bhwgd', xg[:, i:i+H, j:j+W, :, :], w[i, j])
    return out.reshape(B, H, W, C)
```

```asm
; @launch grid=(252,1,1) block=(256,1,1) lds=163840
.amdgcn_target "amdgcn-amd-amdhsa--gfx950"
.text
.globl standalone__grouped__vision_kernel
.p2align 12
.p2align 8
.type standalone__grouped__vision_kernel,@function
standalone__grouped__vision_kernel:
  s_load_dwordx4 s[4:7], s[0:1], 0
  s_load_dwordx2 s[16:17], s[0:1], 16
  s_load_dwordx2 s[32:33], s[0:1], 32
  s_cmp_ge_u32 s2, 252
  s_cbranch_scc1 L_end
  s_lshr_b32 s21, s2, 3
  v_lshrrev_b32 v1, 6, v0
  s_getpc_b64 s[40:41]
L_pc:
  v_lshl_add_u32 v7, s21, 2, v1
  v_lshlrev_b32 v7, 7, v7
  v_min_u32 v7, L_pad-L_pc-4, v7
  global_load_dword v165, v7, s[40:41]
  v_add_u32 v4, 64, v0
  v_readfirstlane_b32 s23, v1
  v_lshrrev_b32 v4, 4, v4
  v_and_b32 v4, 16, v4
  v_sub_u32 v4, v0, v4
  v_mul_u32_u24 v2, 1366, v4
  s_and_b32 s20, s2, 7
  s_min_u32 s22, s20, 4
  s_mul_i32 s20, s20, 31
  s_add_u32 s22, s21, s22
  s_add_u32 s22, s22, s20
  s_and_b32 s42, s22, 1
  s_lshr_b32 s30, s22, 1
  s_mul_i32 s43, s30, 4682
  s_lshr_b32 s43, s43, 16
  s_mul_i32 s22, s43, 14
  s_sub_u32 s22, s30, s22
  s_mul_i32 s39, s22, 3072
  s_sub_u32 s24, s39, 384
  v_bfe_u32 v2, v2, 16, 2
  v_xor_b32 v4, v4, v2
  v_lshl_add_u32 v4, v4, 4, s24
  v_cmp_gt_u32 vcc, 43008, v4
  v_bfrev_b32 v5, 1
  s_mul_i32 s28, s42, 43008
  s_sub_u32 s3, 47104, s28
  s_add_u32 s31, s28, 256
  v_cndmask_b32 v4, v5, v4, vcc
  v_add_u32 v9, s3, v4
  v_add_u32 v10, s31, v4
  s_mul_i32 s20, s43, 25
  s_add_u32 s29, s20, 16
  s_mul_i32 s29, s29, 43008
  s_lshl_b32 s28, s28, 1
  s_sub_u32 s29, s29, s28
  s_sub_u32 s28, s28, 43008
  s_lshl_b32 s96, s28, 1
  s_cmp_eq_u32 s23, 3
  s_cselect_b32 s26, 0xffff0000, -1
  s_mov_b32 s27, -1
  s_lshl_b32 s25, s23, 10
  s_min_u32 s25, s25, 2816
  s_mov_b32 s10, 9809920
  s_mov_b32 s11, 0x20000
  s_mov_b32 m0, s25
  s_mov_b64 exec, s[26:27]
  s_waitcnt lgkmcnt(0)
  s_sub_u32 s8, s4, 176128
  s_subb_u32 s9, s5, 0
  buffer_load_dwordx4 v9, s[8:11], s29 offen  lds
  buffer_load_dwordx4 v10, s[8:11], s29 offen offset:3840  lds
  s_add_u32 m0, s25, 7680
  s_add_u32 s29, s29, s96
  buffer_load_dwordx4 v9, s[8:11], s29 offen  lds
  buffer_load_dwordx4 v10, s[8:11], s29 offen offset:3840  lds
  s_mov_b64 exec, -1
  s_sub_u32 s12, s6, 4096
  s_subb_u32 s13, s7, 0
  s_mov_b32 s14, 119296
  s_mov_b32 s15, 0x20000
  v_and_b32 v6, 63, v0
  v_xor_b32 v8, 63, v6
  v_lshlrev_b32 v8, 7, v8
  s_min_u32 s99, s21, 29
  s_min_u32 s97, s21, 26
  s_cmp_lt_u32 s99, 15
  s_cselect_b32 s38, 0, 69120
  s_lshl2_add_u32 s99, s99, s23
  s_mul_i32 s99, s99, 384
  s_add_u32 s38, s38, s99
  s_add_u32 s38, s38, 4096
  s_lshl2_add_u32 s97, s97, s23
  s_mul_i32 s97, s97, 640
  s_add_u32 s97, s97, 27136
  v_min_u32 v156, 256, v8
  v_min_u32 v157, 512, v8
  buffer_load_dword v164, v156, s[12:15], s38 offen
  s_add_u32 m0, s25, 15360
  s_add_u32 s29, s29, s96
  s_mov_b64 exec, s[26:27]
  buffer_load_dwordx4 v9, s[8:11], s29 offen  lds
  buffer_load_dwordx4 v10, s[8:11], s29 offen offset:3840  lds
  s_mov_b64 exec, -1
  v_lshlrev_b32 v11, 4, v6
  s_mov_b32 s21, s39
  s_mul_i32 s22, s23, 24192
  s_mul_i32 s100, s23, 1152
  s_mul_i32 s99, s42, 46080
  s_add_u32 s100, s100, 92160
  s_lshl_b32 s98, s99, 1
  s_sub_u32 s100, s100, s98
  s_sub_u32 s99, s99, 23040
  s_mov_b32 s98, s10
  s_mov_b32 s18, 9633792
  s_mov_b32 s19, 0x20000
  s_mul_i32 s39, s42, 14
  s_add_u32 s30, s30, s39
  s_movk_i32 s3, 4224
  s_movk_i32 s31, -1152
  v_mul_u32_u24 v4, 2731, v6
  v_add_u32 v5, 4096, v11
  v_bfe_u32 v3, v4, 16, 2
  v_mad_u32_u24 v13, v3, s3, v5
  s_add_u32 m0, s22, 66432
  s_nop 0
  buffer_load_dwordx4 v13, s[12:15], s100 offen offset:0  lds
  v_add_u32 v2, 174784, v4
  v_bfe_u32 v3, v2, 16, 2
  v_mad_u32_u24 v14, v3, s3, v5
  v_lshrrev_b32 v2, 18, v2
  v_mad_i32_i24 v14, v2, s31, v14
  buffer_load_dwordx4 v14, s[12:15], s100 offen offset:1024  lds
  buffer_load_dword v164, v157, s[12:15], s97 offen
  v_add_u32 v2, 349568, v4
  v_bfe_u32 v3, v2, 16, 2
  v_mad_u32_u24 v15, v3, s3, v5
  v_lshrrev_b32 v2, 18, v2
  v_mad_i32_i24 v15, v2, s31, v15
  buffer_load_dwordx4 v15, s[12:15], s100 offen offset:2048  lds
  v_subrev_u32 v16, 2304, v13
  buffer_load_dwordx4 v16, s[12:15], s100 offen offset:3072  lds
  v_cmp_gt_u32 vcc, 32, v6
  v_add_u32 v2, 1792, v14
  v_add_u32 v3, 17920, v5
  v_cndmask_b32 v17, v3, v2, vcc
  v_cmp_gt_u32 vcc, 40, v6
  v_bfrev_b32 v2, 1
  s_nop 0
  v_cndmask_b32 v18, v2, v3, vcc
  s_sub_u32 s30, s30, 14
  s_cmp_lt_u32 s30, 112
  s_cselect_b32 s41, s98, 0
  s_cselect_b32 s43, 1, 0
  v_lshrrev_b32 v1, 4, v6
  v_and_b32 v2, 15, v6
  s_mul_i32 s3, s23, 3
  s_add_u32 s4, s3, 1
  s_add_u32 s5, s3, 2
  v_add_u32 v3, v1, v2
  v_bfe_u32 v4, v3, 2, 2
  v_mul_u32_u24 v3, 192, v3
  v_xor_b32 v5, s3, v4
  v_lshl_add_u32 v19, v5, 4, v3
  v_xor_b32 v5, s4, v4
  v_lshl_add_u32 v20, v5, 4, v3
  v_xor_b32 v5, s5, v4
  v_lshl_add_u32 v21, v5, 4, v3
  v_add_u32 v22, 4, v2
  v_bfe_u32 v24, v22, 2, 2
  v_mul_u32_u24 v23, 192, v22
  v_min_u32 v5, 2, v1
  v_add_u32 v5, s3, v5
  v_xor_b32 v5, v5, v24
  v_lshl_add_u32 v25, v5, 4, v23
  v_bfe_u32 v3, v6, 2, 2
  v_and_b32 v4, 3, v6
  s_add_u32 s31, s22, 65280
  v_mul_u32_u24 v5, 48, v3
  v_lshl_add_u32 v5, v4, 3, v5
  v_add_u32 v7, s31, v5
  v_mul_u32_u24 v5, 384, v1
  v_add_u32 v26, v7, v5
  v_and_b32 v3, 2, v3
  v_and_b32 v4, 2, v4
  v_add3_u32 v31, v26, v5, 32
  v_mad_u32_u24 v31, v3, 48, v31
  v_mad_u32_u24 v31, v4, 40, v31
  v_cmp_eq_u32 s[6:7], 3, v1
  v_cmp_gt_u32 vcc, 8, v2
  v_mov_b32 v8, 162048
  v_mov_b32 v3, 0xeeee
  v_mov_b32 v4, 0x4444
  v_cndmask_b32 v12, v3, v4, vcc
  v_add_u32 v5, 4608, v31
  v_cndmask_b32 v32, v5, v8, s[6:7]
  v_add_u32 v4, 5760, v26
  v_cndmask_b32 v29, v4, v8, s[6:7]
  v_mov_b64 v[104:105], 0
  v_mov_b64 v[106:107], 0
  v_mov_b64 v[108:109], 0
  v_mov_b64 v[110:111], 0
  v_mov_b64 v[112:113], 0
  v_mov_b64 v[114:115], 0
  v_mov_b64 v[116:117], 0
  v_mov_b64 v[118:119], 0
  v_mov_b64 v[120:121], 0
  v_mov_b64 v[122:123], 0
  v_mov_b64 v[124:125], 0
  v_mov_b64 v[126:127], 0
  v_mov_b64 v[128:129], 0
  v_mov_b64 v[130:131], 0
  v_mov_b64 v[132:133], 0
  v_mov_b64 v[134:135], 0
  v_mov_b64 v[136:137], 0
  v_mov_b64 v[138:139], 0
  v_mov_b64 v[140:141], 0
  v_mov_b64 v[142:143], 0
  v_mov_b64 v[144:145], 0
  v_mov_b64 v[146:147], 0
  v_mov_b64 v[148:149], 0
  v_mov_b64 v[150:151], 0
  v_mov_b64 v[152:153], 0
  v_mov_b64 v[154:155], 0
  v_add_u32 v3, v8, v11
  ds_write_b128 v3, v[104:107]
  s_mov_b32 s34, 1077248
  s_mov_b32 s35, 0x20000
  v_add_u32 v5, 10368, v31
  v_cndmask_b32 v33, v5, v8, s[6:7]
  v_add_u32 v5, 16128, v31
  v_cndmask_b32 v34, v5, v8, s[6:7]
  v_add_u32 v5, 21888, v31
  v_cndmask_b32 v35, v5, v8, s[6:7]
  v_add_u32 v5, 3456, v31
  v_cndmask_b32 v36, v5, v8, s[6:7]
  v_add_u32 v4, 4608, v26
  v_cndmask_b32 v30, v4, v8, s[6:7]
  s_sub_u32 s31, s42, 1
  s_and_b32 s31, s31, 3
  v_xor_b32 v8, s31, v1
  v_cmp_eq_u32 s[6:7], 3, v8
  v_mul_u32_u24 v5, 3840, v8
  v_add_u32 v3, v23, v5
  v_mov_b32 v4, v24
  v_xor_b32 v5, s3, v4
  v_lshl_add_u32 v22, v5, 4, v3
  v_xor_b32 v5, s4, v4
  v_lshl_add_u32 v23, v5, 4, v3
  v_xor_b32 v5, s5, v4
  v_lshl_add_u32 v24, v5, 4, v3
  v_mul_u32_u24 v3, 5760, v8
  v_add_u32 v3, 5760, v3
  v_add_u32 v27, v7, v3
  v_add_u32 v3, 5760, v27
  v_add_u32 v4, 4608, v7
  v_cndmask_b32 v28, v3, v4, s[6:7]
  s_lshl_b32 s30, s30, 8
  s_add_u32 s30, s30, 1048576
  v_mov_b32 v3, s30
  v_cmp_gt_u32 vcc, s43, v0
  v_bfrev_b32 v4, 1
  v_mov_b32 v49, 0
  v_cndmask_b32 v47, v4, v3, vcc
  v_mul_u32_u24 v3, 192, v2
  v_and_b32 v5, 1, v1
  v_lshl_add_u32 v3, v5, 3, v3
  v_add_u32 v3, 65280, v3
  v_bfe_u32 v5, v2, 1, 2
  v_lshrrev_b32 v4, 1, v1
  v_lshl_add_u32 v38, v4, 2, v3
  v_add_u32 v4, s3, v4
  v_xor_b32 v4, v4, v5
  v_lshl_add_u32 v37, v4, 4, v3
  v_xor_b32 v4, s5, v5
  v_lshl_add_u32 v38, v4, 4, v38
  s_lshl_b32 s4, s23, 2
  s_add_u32 s4, s4, 162560
  v_mov_b32 v45, s4
  v_and_b32 v3, 3, v6
  v_lshlrev_b32 v3, 2, v3
  v_add_u32 v46, 162560, v3
  s_mul_i32 s4, s23, 3072
  s_add_u32 s4, s4, 65280
  s_mul_i32 s5, s23, 48
  s_mov_b32 s3, 65280
  v_mul_u32_u24 v4, 2731, v6
  v_bfe_u32 v4, v4, 16, 2
  v_xor_b32 v3, v6, v4
  v_lshl_add_u32 v41, v3, 4, s4
  v_add_u32 v3, 64, v6
  v_mul_u32_u24 v4, 2731, v3
  v_bfe_u32 v4, v4, 16, 2
  v_xor_b32 v3, v3, v4
  v_lshl_add_u32 v42, v3, 4, s4
  v_add_u32 v3, 128, v6
  v_mul_u32_u24 v4, 2731, v3
  v_bfe_u32 v4, v4, 16, 2
  v_xor_b32 v3, v3, v4
  v_lshl_add_u32 v43, v3, 4, s4
  v_add_u32 v3, s5, v6
  v_mul_u32_u24 v4, 2731, v3
  v_bfe_u32 v4, v4, 16, 2
  v_xor_b32 v3, v3, v4
  v_lshl_add_u32 v39, v3, 4, s3
  v_add_u32 v44, s21, v11
  s_mul_i32 s4, s23, 768
  v_cmp_gt_u32 vcc, 48, v6
  v_add_u32 v3, s4, v44
  v_bfrev_b32 v5, 1
  v_cndmask_b32 v40, v5, v3, vcc
  s_add_u32 s24, s20, s42
  s_add_u32 s24, s24, 11
  s_mul_i32 s24, s24, 43008
  s_mul_i32 s4, s23, s28
  s_add_u32 s40, s24, s4
  s_mul_i32 s3, s28, 4
  s_add_u32 s3, s3, s40
  s_mul_i32 s4, s28, 8
  s_add_u32 s4, s4, s24
  s_mul_i32 s5, s28, 9
  s_add_u32 s5, s5, s24
  s_mul_i32 s6, s28, 10
  s_add_u32 s6, s6, s24
  s_mul_i32 s7, s28, 11
  s_add_u32 s7, s7, s24
  s_mul_i32 s0, s28, 12
  s_add_u32 s0, s0, s24
  s_add_u32 m0, s22, 70528
  s_nop 0
  buffer_load_dwordx4 v17, s[12:15], s100 offen offset:0  lds
  buffer_load_dwordx4 v18, s[12:15], s100 offen offset:1024  lds
  s_add_u32 m0, s22, 72192
  s_add_u32 s100, s100, s99
  buffer_load_dwordx4 v13, s[12:15], s100 offen offset:0  lds
  s_mov_b64 exec, 0
  s_cmp_eq_u32 s23, 1
  s_cbranch_scc1 L_visit1
  s_cmp_eq_u32 s23, 2
  s_cbranch_scc1 L_visit2
  s_cmp_eq_u32 s23, 3
  s_cbranch_scc1 L_visit3
L_back:
  s_mov_b64 exec, -1
  s_branch L_main
.p2align 12
L_main:
  s_waitcnt vmcnt(11)
  s_barrier
  ds_read_b128 v[192:195], v19 offset:0
  ds_read_b128 v[200:203], v19 offset:3840
  ds_read_b128 v[208:211], v19 offset:7680
  ds_read_b128 v[216:219], v19 offset:11520
  ds_read_b128 v[196:199], v20 offset:0
  ds_read_b128 v[204:207], v20 offset:3840
  buffer_load_dwordx4 v14, s[12:15], s100 offen offset:1024  lds
  ds_read_b128 v[212:215], v20 offset:7680
  ds_read_b128 v[220:223], v20 offset:11520
  ds_read_b128 v[224:227], v21 offset:0
  ds_read_b128 v[232:235], v21 offset:3840
  ds_read_b128 v[240:243], v21 offset:7680
  ds_read_b128 v[248:251], v21 offset:11520
  buffer_load_dwordx4 v15, s[12:15], s100 offen offset:2048  lds
  ds_read_b128 v[228:231], v25 offset:0
  ds_read_b128 v[236:239], v25 offset:3840
  s_waitcnt lgkmcnt(13)
  ds_read_b128 v[244:247], v25 offset:7680
  ds_read_b128 v[252:255], v25 offset:11520
  buffer_load_dwordx4 v16, s[12:15], s100 offen offset:3072  lds
  s_add_u32 m0, s22, 76288
  s_nop 0
  buffer_load_dwordx4 v17, s[12:15], s100 offen offset:0  lds
  s_waitcnt vmcnt(12)
  s_barrier
  s_waitcnt lgkmcnt(13)
  ds_read_b128 a[132:135], v19 offset:15360
  ds_read_b128 a[140:143], v19 offset:19200
  s_waitcnt lgkmcnt(13)
  ds_read_b128 a[136:139], v20 offset:15360
  ds_read_b128 a[144:147], v20 offset:19200
  buffer_load_dwordx4 v18, s[12:15], s100 offen offset:1024  lds
  s_add_u32 m0, s22, 77952
  s_add_u32 s100, s100, s99
  buffer_load_dwordx4 v13, s[12:15], s100 offen offset:0  lds
  s_waitcnt vmcnt(12) lgkmcnt(13)
  ds_read_b64_tr_b16 a[0:1], v26 offset:1152
  ds_read_b64_tr_b16 a[2:3], v26 offset:1344
  s_waitcnt lgkmcnt(0)
  v_mfma_f32_16x16x32_bf16 v[52:55], a[0:3], v[192:195], 0
  buffer_load_dwordx4 v14, s[12:15], s100 offen offset:1024  lds
  v_mfma_f32_16x16x32_bf16 v[56:59], a[0:3], v[200:203], 0
  s_waitcnt vmcnt(11)
  ds_read_b64_tr_b16 a[4:5], v26 offset:2688
  v_mfma_f32_16x16x32_bf16 v[60:63], a[0:3], v[208:211], 0
  ds_read_b64_tr_b16 a[6:7], v26 offset:2880
  v_mfma_f32_16x16x32_bf16 v[64:67], a[0:3], v[216:219], 0
  ds_read_b64_tr_b16 a[12:13], v31 offset:1152
  v_mfma_f32_16x16x32_bf16 v[68:71], a[0:3], a[132:135], 0
  buffer_load_dwordx4 v15, s[12:15], s100 offen offset:2048  lds
  v_mfma_f32_16x16x32_bf16 v[72:75], a[0:3], a[140:143], 0
  ds_read_b64_tr_b16 a[14:15], v31 offset:1536
  s_waitcnt lgkmcnt(2)
  v_mfma_f32_16x16x32_bf16 v[52:55], a[4:7], v[196:199], v[52:55]
  ds_read_b128 a[148:151], v21 offset:15360
  v_mfma_f32_16x16x32_bf16 v[56:59], a[4:7], v[204:207], v[56:59]
  ds_read_b128 a[156:159], v21 offset:19200
  v_mfma_f32_16x16x32_bf16 v[60:63], a[4:7], v[212:215], v[60:63]
  buffer_load_dwordx4 v16, s[12:15], s100 offen offset:3072  lds
  v_mfma_f32_16x16x32_bf16 v[64:67], a[4:7], v[220:223], v[64:67]
  s_add_u32 m0, s22, 82048
  ds_read_b128 a[152:155], v25 offset:15360
  v_mfma_f32_16x16x32_bf16 v[68:71], a[4:7], a[136:139], v[68:71]
  s_waitcnt vmcnt(10)
  ds_read_b64_tr_b16 a[8:9], v26 offset:4224
  v_mfma_f32_16x16x32_bf16 v[72:75], a[4:7], a[144:147], v[72:75]
  ds_read_b64_tr_b16 a[10:11], v26 offset:4416
  s_waitcnt lgkmcnt(4)
  v_smfmac_f32_16x16x64_bf16 v[104:107], a[12:15], v[192:199], v12
  buffer_load_dwordx4 v17, s[12:15], s100 offen offset:0  lds
  v_smfmac_f32_16x16x64_bf16 v[108:111], a[12:15], v[200:207], v12
  ds_read_b64_tr_b16 a[16:17], v31 offset:4224
  v_smfmac_f32_16x16x64_bf16 v[112:115], a[12:15], v[208:215], v12
  ds_read_b64_tr_b16 a[18:19], v32 offset:0
  v_smfmac_f32_16x16x64_bf16 v[116:119], a[12:15], v[216:223], v12
  ds_read_b64_tr_b16 a[124:125], v29 offset:0
  v_smfmac_f32_16x16x64_bf16 v[120:123], a[12:15], a[132:139], v12
  buffer_load_dwordx4 v18, s[12:15], s100 offen offset:1024  lds
  v_smfmac_f32_16x16x64_bf16 v[124:127], a[12:15], a[140:147], v12
  s_add_u32 m0, s25, 23040
  ds_read_b64_tr_b16 a[126:127], v29 offset:192
  s_waitcnt lgkmcnt(4)
  v_mfma_f32_16x16x32_bf16 v[52:55], a[8:11], v[224:227], v[52:55]
  s_add_u32 s29, s29, s96
  ds_read_b128 a[160:163], v25 offset:19200
  v_mfma_f32_16x16x32_bf16 v[56:59], a[8:11], v[232:235], v[56:59]
  v_mfma_f32_16x16x32_bf16 v[60:63], a[8:11], v[240:243], v[60:63]
  buffer_load_dwordx4 v9, s[8:11], s29 offen  lds
  v_mfma_f32_16x16x32_bf16 v[68:71], a[8:11], a[148:151], v[68:71]
  v_mfma_f32_16x16x32_bf16 v[64:67], a[8:11], v[248:251], v[64:67]
  s_waitcnt lgkmcnt(1)
  v_smfmac_f32_16x16x64_bf16 v[104:107], a[16:19], v[224:231], v12
  v_smfmac_f32_16x16x64_bf16 v[108:111], a[16:19], v[232:239], v12
  s_waitcnt vmcnt(7)
  ds_read_b64_tr_b16 a[20:21], v26 offset:6912
  v_smfmac_f32_16x16x64_bf16 v[112:115], a[16:19], v[240:247], v12
  buffer_load_dwordx4 v10, s[8:11], s29 offen offset:3840  lds
  v_mfma_f32_16x16x32_bf16 v[72:75], a[8:11], a[156:159], v[72:75]
  s_waitcnt lgkmcnt(1)
  ds_read_b64_tr_b16 a[22:23], v26 offset:7104
  v_mfma_f32_16x16x32_bf16 v[72:75], a[124:127], a[160:163], v[72:75]
  s_add_u32 m0, s25, 30720
  s_add_u32 s29, s29, s96
  v_smfmac_f32_16x16x64_bf16 v[124:127], a[16:19], a[156:163], v12
  buffer_load_dwordx4 v9, s[8:11], s29 offen  lds
  v_mfma_f32_16x16x32_bf16 v[56:59], a[124:127], v[236:239], v[56:59]
  s_add_u32 m0, s22, 83712
  ds_read_b64_tr_b16 a[24:25], v26 offset:8448
  v_mfma_f32_16x16x32_bf16 v[64:67], a[124:127], v[252:255], v[64:67]
  s_add_u32 s100, s100, s99
  ds_read_b64_tr_b16 a[26:27], v26 offset:8640
  v_smfmac_f32_16x16x64_bf16 v[116:119], a[16:19], v[248:255], v12
  ds_read_b64_tr_b16 a[28:29], v26 offset:9984
  v_smfmac_f32_16x16x64_bf16 v[120:123], a[16:19], a[148:155], v12
  buffer_load_dwordx4 v13, s[12:15], s100 offen offset:0  lds
  s_waitcnt lgkmcnt(3)
  v_mfma_f32_16x16x32_bf16 v[52:55], a[20:23], v[200:203], v[52:55]
  ds_read_b64_tr_b16 a[30:31], v26 offset:10176
  v_mfma_f32_16x16x32_bf16 v[56:59], a[20:23], v[208:211], v[56:59]
  ds_read_b64_tr_b16 a[32:33], v31 offset:6912
  v_mfma_f32_16x16x32_bf16 v[60:63], a[20:23], v[216:219], v[60:63]
  ds_read_b64_tr_b16 a[34:35], v31 offset:7296
  v_mfma_f32_16x16x32_bf16 v[64:67], a[20:23], a[132:135], v[64:67]
  buffer_load_dwordx4 v14, s[12:15], s100 offen offset:1024  lds
  v_mfma_f32_16x16x32_bf16 v[68:71], a[20:23], a[140:143], v[68:71]
  ds_read_b64_tr_b16 a[36:37], v31 offset:9984
  s_waitcnt lgkmcnt(4)
  v_mfma_f32_16x16x32_bf16 v[52:55], a[24:27], v[204:207], v[52:55]
  ds_read_b64_tr_b16 a[38:39], v33 offset:0
  v_mfma_f32_16x16x32_bf16 v[56:59], a[24:27], v[212:215], v[56:59]
  ds_read_b128 v[168:171], v22 offset:0
  v_mfma_f32_16x16x32_bf16 v[60:63], a[24:27], v[220:223], v[60:63]
  buffer_load_dwordx4 v15, s[12:15], s100 offen offset:2048  lds
  v_mfma_f32_16x16x32_bf16 v[64:67], a[24:27], a[136:139], v[64:67]
  s_waitcnt lgkmcnt(3)
  ds_read_b128 v[172:175], v23 offset:0
  v_mfma_f32_16x16x32_bf16 v[64:67], a[28:31], a[148:151], v[64:67]
  ds_read_b128 v[176:179], v24 offset:0
  v_mfma_f32_16x16x32_bf16 v[52:55], a[28:31], v[232:235], v[52:55]
  ds_read_b128 v[180:183], v22 offset:7680
  v_mfma_f32_16x16x32_bf16 v[56:59], a[28:31], v[240:243], v[56:59]
  buffer_load_dwordx4 v16, s[12:15], s100 offen offset:3072  lds
  v_mfma_f32_16x16x32_bf16 v[60:63], a[28:31], v[248:251], v[60:63]
  s_add_u32 m0, s22, 87808
  ds_read_b128 v[184:187], v23 offset:7680
  v_smfmac_f32_16x16x64_bf16 v[104:107], a[32:35], v[200:207], v12
  s_waitcnt lgkmcnt(3)
  ds_read_b128 v[188:191], v24 offset:7680
  v_smfmac_f32_16x16x64_bf16 v[104:107], a[36:39], v[232:239], v12
  v_smfmac_f32_16x16x64_bf16 v[108:111], a[32:35], v[208:215], v12
  s_waitcnt vmcnt(7)
  ds_read_b64_tr_b16 a[40:41], v26 offset:12672
  v_smfmac_f32_16x16x64_bf16 v[108:111], a[36:39], v[240:247], v12
  buffer_load_dwordx4 v17, s[12:15], s100 offen offset:0  lds
  v_mfma_f32_16x16x32_bf16 v[68:71], a[24:27], a[144:147], v[68:71]
  ds_read_b64_tr_b16 a[42:43], v26 offset:12864
  v_mfma_f32_16x16x32_bf16 v[68:71], a[28:31], a[156:159], v[68:71]
  ds_read_b64_tr_b16 a[44:45], v26 offset:14208
  s_mov_b32 exec_hi, 0xff
  v_smfmac_f32_16x16x64_bf16 v[120:123], a[32:35], a[140:147], v12
  buffer_load_dwordx4 v18, s[12:15], s100 offen offset:1024  lds
  v_smfmac_f32_16x16x64_bf16 v[120:123], a[36:39], a[156:163], v12
  s_add_u32 m0, s22, 65280
  s_mov_b64 exec, -1
  v_smfmac_f32_16x16x64_bf16 v[112:115], a[32:35], v[216:223], v12
  s_add_u32 s100, s100, s99
  ds_read_b64_tr_b16 a[46:47], v26 offset:14400
  v_smfmac_f32_16x16x64_bf16 v[112:115], a[36:39], v[248:255], v12
  ds_read_b64_tr_b16 a[48:49], v26 offset:15744
  v_smfmac_f32_16x16x64_bf16 v[116:119], a[32:35], a[132:139], v12
  buffer_load_dwordx4 v13, s[12:15], s100 offen offset:0  lds
  v_smfmac_f32_16x16x64_bf16 v[116:119], a[36:39], a[148:155], v12
  ds_read_b64_tr_b16 a[50:51], v26 offset:15936
  s_waitcnt lgkmcnt(3)
  v_mfma_f32_16x16x32_bf16 v[52:55], a[40:43], v[208:211], v[52:55]
  ds_read_b64_tr_b16 a[52:53], v31 offset:12672
  v_mfma_f32_16x16x32_bf16 v[56:59], a[40:43], v[216:219], v[56:59]
  ds_read_b64_tr_b16 a[54:55], v31 offset:13056
  v_mfma_f32_16x16x32_bf16 v[60:63], a[40:43], a[132:135], v[60:63]
  buffer_load_dwordx4 v14, s[12:15], s100 offen offset:1024  lds
  v_mfma_f32_16x16x32_bf16 v[64:67], a[40:43], a[140:143], v[64:67]
  ds_read_b64_tr_b16 a[56:57], v31 offset:15744
  s_waitcnt lgkmcnt(4)
  v_mfma_f32_16x16x32_bf16 v[52:55], a[44:47], v[212:215], v[52:55]
  ds_read_b64_tr_b16 a[58:59], v34 offset:0
  v_mfma_f32_16x16x32_bf16 v[56:59], a[44:47], v[220:223], v[56:59]
  v_mfma_f32_16x16x32_bf16 v[60:63], a[44:47], a[136:139], v[60:63]
  v_mfma_f32_16x16x32_bf16 v[64:67], a[44:47], a[144:147], v[64:67]
  s_waitcnt vmcnt(8) lgkmcnt(2)
  s_barrier
  v_mfma_f32_16x16x32_bf16 v[64:67], a[48:51], a[156:159], v[64:67]
  ds_read_b128 a[164:167], v19 offset:23040
  v_mfma_f32_16x16x32_bf16 v[52:55], a[48:51], v[240:243], v[52:55]
  ds_read_b128 a[168:171], v20 offset:23040
  v_mfma_f32_16x16x32_bf16 v[56:59], a[48:51], v[248:251], v[56:59]
  ds_read_b128 a[172:175], v21 offset:23040
  v_mfma_f32_16x16x32_bf16 v[60:63], a[48:51], a[148:151], v[60:63]
  ds_read_b128 a[176:179], v25 offset:23040
  v_smfmac_f32_16x16x64_bf16 v[104:107], a[52:55], v[208:215], v12
  s_waitcnt lgkmcnt(4)
  ds_read_b128 a[180:183], v19 offset:26880
  v_smfmac_f32_16x16x64_bf16 v[104:107], a[56:59], v[240:247], v12
  buffer_load_dwordx4 v15, s[12:15], s100 offen offset:2048  lds
  v_smfmac_f32_16x16x64_bf16 v[108:111], a[52:55], v[216:223], v12
  ds_read_b128 a[184:187], v20 offset:26880
  v_smfmac_f32_16x16x64_bf16 v[108:111], a[56:59], v[248:255], v12
  ds_read_b128 a[188:191], v21 offset:26880
  v_smfmac_f32_16x16x64_bf16 v[112:115], a[52:55], a[132:139], v12
  ds_read_b128 a[192:195], v25 offset:26880
  v_smfmac_f32_16x16x64_bf16 v[112:115], a[56:59], a[148:155], v12
  buffer_load_dwordx4 v16, s[12:15], s100 offen offset:3072  lds
  v_smfmac_f32_16x16x64_bf16 v[116:119], a[52:55], a[140:147], v12
  s_add_u32 m0, s22, 69376
  ds_read_b128 a[196:199], v19 offset:30720
  v_smfmac_f32_16x16x64_bf16 v[116:119], a[56:59], a[156:163], v12
  s_waitcnt lgkmcnt(3)
  ds_read_b128 a[200:203], v20 offset:30720
  v_mfma_f32_16x16x32_bf16 v[68:71], a[40:43], a[164:167], v[68:71]
  ds_read_b128 a[204:207], v21 offset:30720
  v_mfma_f32_16x16x32_bf16 v[68:71], a[44:47], a[168:171], v[68:71]
  buffer_load_dwordx4 v17, s[12:15], s100 offen offset:0  lds
  v_mfma_f32_16x16x32_bf16 v[68:71], a[48:51], a[172:175], v[68:71]
  ds_read_b128 a[208:211], v25 offset:30720
  v_smfmac_f32_16x16x64_bf16 v[120:123], a[52:55], a[164:171], v12
  v_smfmac_f32_16x16x64_bf16 v[120:123], a[56:59], a[172:179], v12
  s_mov_b32 exec_hi, 0xff
  v_mfma_f32_16x16x32_bf16 v[72:75], a[20:23], a[164:167], v[72:75]
  buffer_load_dwordx4 v18, s[12:15], s100 offen offset:1024  lds
  v_mfma_f32_16x16x32_bf16 v[72:75], a[24:27], a[168:171], v[72:75]
  s_add_u32 m0, s25, 34560
  s_mov_b64 exec, -1
  v_mfma_f32_16x16x32_bf16 v[72:75], a[28:31], a[172:175], v[72:75]
  s_add_u32 s29, s29, s28
  v_mfma_f32_16x16x32_bf16 v[72:75], a[40:43], a[180:183], v[72:75]
  v_mfma_f32_16x16x32_bf16 v[72:75], a[44:47], a[184:187], v[72:75]
  s_waitcnt lgkmcnt(0)
  v_mfma_f32_16x16x32_bf16 v[72:75], a[48:51], a[188:191], v[72:75]
  buffer_load_dwordx4 v9, s[8:11], s29 offen  lds
  v_smfmac_f32_16x16x64_bf16 v[124:127], a[32:35], a[164:171], v12
  v_smfmac_f32_16x16x64_bf16 v[124:127], a[36:39], a[172:179], v12
  v_smfmac_f32_16x16x64_bf16 v[124:127], a[52:55], a[180:187], v12
  buffer_atomic_add v49, v47, s[32:35], 0 offen sc0 sc1
  v_smfmac_f32_16x16x64_bf16 v[124:127], a[56:59], a[188:195], v12
  v_mfma_f32_16x16x32_bf16 v[76:79], a[0:3], a[164:167], 0
  v_mfma_f32_16x16x32_bf16 v[76:79], a[4:7], a[168:171], v[76:79]
  v_mfma_f32_16x16x32_bf16 v[76:79], a[8:11], a[172:175], v[76:79]
  s_waitcnt vmcnt(8)
  ds_read_b64_tr_b16 a[60:61], v26 offset:18432
  v_mfma_f32_16x16x32_bf16 v[76:79], a[20:23], a[180:183], v[76:79]
  ds_read_b64_tr_b16 a[62:63], v26 offset:18624
  v_mfma_f32_16x16x32_bf16 v[76:79], a[24:27], a[184:187], v[76:79]
  ds_read_b64_tr_b16 a[64:65], v26 offset:19968
  v_mfma_f32_16x16x32_bf16 v[76:79], a[28:31], a[188:191], v[76:79]
  ds_read_b64_tr_b16 a[66:67], v26 offset:20160
  v_mfma_f32_16x16x32_bf16 v[76:79], a[40:43], a[196:199], v[76:79]
  ds_read_b64_tr_b16 a[68:69], v26 offset:21504
  v_mfma_f32_16x16x32_bf16 v[76:79], a[44:47], a[200:203], v[76:79]
  ds_read_b64_tr_b16 a[70:71], v26 offset:21696
  v_mfma_f32_16x16x32_bf16 v[76:79], a[48:51], a[204:207], v[76:79]
  ds_read_b64_tr_b16 a[72:73], v31 offset:18432
  v_smfmac_f32_16x16x64_bf16 v[128:131], a[12:15], a[164:171], v12
  ds_read_b64_tr_b16 a[74:75], v31 offset:18816
  v_smfmac_f32_16x16x64_bf16 v[128:131], a[16:19], a[172:179], v12
  buffer_load_dwordx4 v10, s[8:11], s29 offen offset:3840  lds
  v_smfmac_f32_16x16x64_bf16 v[128:131], a[32:35], a[180:187], v12
  ds_read_b64_tr_b16 a[76:77], v31 offset:21504
  v_smfmac_f32_16x16x64_bf16 v[128:131], a[36:39], a[188:195], v12
  ds_read_b64_tr_b16 a[78:79], v35 offset:0
  v_smfmac_f32_16x16x64_bf16 v[128:131], a[52:55], a[196:203], v12
  ds_read_b64_tr_b16 a[100:101], v27 offset:0
  v_smfmac_f32_16x16x64_bf16 v[128:131], a[56:59], a[204:211], v12
  ds_read_b64_tr_b16 a[102:103], v27 offset:192
  v_mfma_f32_16x16x32_bf16 v[80:83], a[0:3], a[180:183], 0
  ds_read_b64_tr_b16 a[108:109], v27 offset:384
  v_mfma_f32_16x16x32_bf16 v[80:83], a[4:7], a[184:187], v[80:83]
  ds_read_b64_tr_b16 a[110:111], v27 offset:576
  v_mfma_f32_16x16x32_bf16 v[80:83], a[8:11], a[188:191], v[80:83]
  ds_read_b64_tr_b16 a[116:117], v27 offset:768
  v_mfma_f32_16x16x32_bf16 v[80:83], a[20:23], a[196:199], v[80:83]
  s_waitcnt vmcnt(3) lgkmcnt(13)
  ds_read_b64_tr_b16 a[80:81], v26 offset:0
  v_mfma_f32_16x16x32_bf16 v[80:83], a[24:27], a[200:203], v[80:83]
  ds_read_b64_tr_b16 a[82:83], v26 offset:192
  v_mfma_f32_16x16x32_bf16 v[80:83], a[28:31], a[204:207], v[80:83]
  s_waitcnt lgkmcnt(13)
  ds_read_b64_tr_b16 a[84:85], v26 offset:1536
  v_mfma_f32_16x16x32_bf16 v[80:83], a[124:127], a[192:195], v[80:83]
  s_waitcnt lgkmcnt(4)
  ds_read_b64_tr_b16 a[86:87], v26 offset:1728
  v_smfmac_f32_16x16x64_bf16 v[124:127], a[72:75], a[196:203], v12
  ds_read_b64_tr_b16 a[88:89], v26 offset:3072
  v_smfmac_f32_16x16x64_bf16 v[124:127], a[76:79], a[204:211], v12
  ds_read_b64_tr_b16 a[90:91], v26 offset:3264
  v_mfma_f32_16x16x32_bf16 v[72:75], a[60:63], a[196:199], v[72:75]
  s_add_u32 m0, s25, 42240
  ds_read_b64_tr_b16 a[92:93], v31 offset:0
  v_mfma_f32_16x16x32_bf16 v[72:75], a[64:67], a[200:203], v[72:75]
  s_add_u32 s29, s29, s96
  ds_read_b64_tr_b16 a[94:95], v31 offset:384
  v_mfma_f32_16x16x32_bf16 v[72:75], a[68:71], a[204:207], v[72:75]
  ds_read_b64_tr_b16 a[96:97], v31 offset:3072
  v_smfmac_f32_16x16x64_bf16 v[132:135], a[12:15], a[180:187], v12
  buffer_load_dwordx4 v9, s[8:11], s29 offen  lds
  v_smfmac_f32_16x16x64_bf16 v[132:135], a[16:19], a[188:195], v12
  ds_read_b64_tr_b16 a[98:99], v36 offset:0
  v_smfmac_f32_16x16x64_bf16 v[132:135], a[32:35], a[196:203], v12
  ds_read_b64_tr_b16 a[128:129], v30 offset:0
  v_smfmac_f32_16x16x64_bf16 v[132:135], a[36:39], a[204:211], v12
  ds_read_b64_tr_b16 a[130:131], v30 offset:192
  v_smfmac_f32_16x16x64_bf16 v[136:139], a[12:15], a[196:203], v12
  ds_read_b64_tr_b16 a[118:119], v27 offset:960
  v_smfmac_f32_16x16x64_bf16 v[136:139], a[16:19], a[204:211], v12
  ds_read_b64_tr_b16 a[104:105], v28 offset:0
  v_mfma_f32_16x16x32_bf16 v[52:55], a[60:63], v[216:219], v[52:55]
  s_waitcnt lgkmcnt(13)
  ds_read_b64_tr_b16 a[106:107], v28 offset:192
  v_mfma_f32_16x16x32_bf16 v[52:55], a[64:67], v[220:223], v[52:55]
  ds_read_b64_tr_b16 a[112:113], v28 offset:384
  v_mfma_f32_16x16x32_bf16 v[52:55], a[68:71], v[248:251], v[52:55]
  s_waitcnt lgkmcnt(4)
  ds_read_b64_tr_b16 a[114:115], v28 offset:576
  v_mfma_f32_16x16x32_bf16 v[52:55], a[80:83], a[132:135], v[52:55]
  ds_read_b64_tr_b16 a[120:121], v28 offset:768
  v_mfma_f32_16x16x32_bf16 v[52:55], a[84:87], a[136:139], v[52:55]
  ds_read_b64_tr_b16 a[122:123], v28 offset:960
  v_mfma_f32_16x16x32_bf16 v[52:55], a[88:91], a[148:151], v[52:55]
  ds_read_b128 a[252:255], v22 offset:15360
  v_mfma_f32_16x16x32_bf16 v[52:55], a[128:131], a[152:155], v[52:55]
  v_mfma_f32_16x16x32_bf16 v[52:55], a[100:103], v[168:171], v[52:55]
  ds_read_b128 v[168:171], v23 offset:15360
  v_mfma_f32_16x16x32_bf16 v[52:55], a[108:111], v[172:175], v[52:55]
  s_waitcnt lgkmcnt(3)
  ds_read_b128 v[172:175], v24 offset:15360
  v_mfma_f32_16x16x32_bf16 v[52:55], a[116:119], v[176:179], v[52:55]
  ds_write_b32 v45, v12 offset:16
  v_smfmac_f32_16x16x64_bf16 v[104:107], a[72:75], v[216:223], v12
  v_smfmac_f32_16x16x64_bf16 v[104:107], a[76:79], v[248:255], v12
  buffer_load_dwordx4 v10, s[8:11], s29 offen offset:3840  lds
  v_smfmac_f32_16x16x64_bf16 v[104:107], a[92:95], a[132:139], v12
  v_smfmac_f32_16x16x64_bf16 v[104:107], a[96:99], a[148:155], v12
  v_smfmac_f32_16x16x64_bf16 v[108:111], a[72:75], a[132:139], v12
  v_smfmac_f32_16x16x64_bf16 v[108:111], a[76:79], a[148:155], v12
  ds_read_b32 v4, v46 offset:16
  v_cvt_pk_bf16_f32 v52, v52, v53
  v_smfmac_f32_16x16x64_bf16 v[108:111], a[92:95], a[140:147], v12
  v_cvt_pk_bf16_f32 v53, v54, v55
  v_smfmac_f32_16x16x64_bf16 v[108:111], a[96:99], a[156:163], v12
  v_mfma_f32_16x16x32_bf16 v[56:59], a[60:63], a[132:135], v[56:59]
  v_permlane32_swap_b32 v104, v106
  v_mfma_f32_16x16x32_bf16 v[56:59], a[64:67], a[136:139], v[56:59]
  v_permlane32_swap_b32 v105, v107
  v_mfma_f32_16x16x32_bf16 v[56:59], a[68:71], a[148:151], v[56:59]
  s_waitcnt lgkmcnt(0)
  v_cmp_eq_u32 vcc, 0, v4
  v_add_f32 v104, v104, v106
  v_mfma_f32_16x16x32_bf16 v[56:59], a[80:83], a[140:143], v[56:59]
  s_cbranch_vccnz L_retry1
L_cont1:
  v_add_f32 v105, v105, v107
  v_mfma_f32_16x16x32_bf16 v[56:59], a[84:87], a[144:147], v[56:59]
  ds_write_b32 v37, v52 offset:0
  v_mfma_f32_16x16x32_bf16 v[56:59], a[88:91], a[156:159], v[56:59]
  v_cvt_pk_bf16_f32 v104, v104, v105
  v_mfma_f32_16x16x32_bf16 v[56:59], a[104:107], v[180:183], v[56:59]
  ds_write_b32 v37, v53 offset:4
  v_mfma_f32_16x16x32_bf16 v[56:59], a[112:115], v[184:187], v[56:59]
  s_add_u32 m0, s25, 49920
  v_permlane32_swap_b32 v108, v110
  v_mfma_f32_16x16x32_bf16 v[56:59], a[120:123], v[188:191], v[56:59]
  s_add_u32 s29, s29, s96
  v_permlane32_swap_b32 v109, v111
  v_smfmac_f32_16x16x64_bf16 v[112:115], a[72:75], a[140:147], v12
  ds_write_b32 v38, v104 offset:0
  v_smfmac_f32_16x16x64_bf16 v[112:115], a[76:79], a[156:163], v12
  buffer_load_dwordx4 v9, s[8:11], s29 offen  lds
  v_smfmac_f32_16x16x64_bf16 v[112:115], a[92:95], a[164:171], v12
  v_add_f32 v108, v108, v110
  v_smfmac_f32_16x16x64_bf16 v[112:115], a[96:99], a[172:179], v12
  v_add_f32 v109, v109, v111
  v_mfma_f32_16x16x32_bf16 v[60:63], a[60:63], a[140:143], v[60:63]
  v_cvt_pk_bf16_f32 v108, v108, v109
  v_cvt_pk_bf16_f32 v56, v56, v57
  v_mfma_f32_16x16x32_bf16 v[60:63], a[64:67], a[144:147], v[60:63]
  ds_write_b32 v38, v108 offset:3072
  v_mfma_f32_16x16x32_bf16 v[60:63], a[68:71], a[156:159], v[60:63]
  v_cvt_pk_bf16_f32 v57, v58, v59
  v_mfma_f32_16x16x32_bf16 v[60:63], a[80:83], a[164:167], v[60:63]
  ds_write_b32 v37, v56 offset:3072
  v_mfma_f32_16x16x32_bf16 v[60:63], a[84:87], a[168:171], v[60:63]
  v_permlane32_swap_b32 v112, v114
  v_mfma_f32_16x16x32_bf16 v[60:63], a[88:91], a[172:175], v[60:63]
  ds_write_b32 v37, v57 offset:3076
  v_mfma_f32_16x16x32_bf16 v[60:63], a[128:131], a[176:179], v[60:63]
  v_permlane32_swap_b32 v113, v115
  v_mfma_f32_16x16x32_bf16 v[60:63], a[100:103], v[180:183], v[60:63]
  v_add_f32 v112, v112, v114
  v_add_f32 v113, v113, v115
  v_mfma_f32_16x16x32_bf16 v[60:63], a[108:111], v[184:187], v[60:63]
  v_cvt_pk_bf16_f32 v112, v112, v113
  v_mfma_f32_16x16x32_bf16 v[60:63], a[116:119], v[188:191], v[60:63]
  ds_write_b32 v38, v112 offset:6144
  v_smfmac_f32_16x16x64_bf16 v[116:119], a[72:75], a[164:171], v12
  v_smfmac_f32_16x16x64_bf16 v[116:119], a[76:79], a[172:179], v12
  s_mov_b32 s10, s41
  v_smfmac_f32_16x16x64_bf16 v[116:119], a[92:95], a[180:187], v12
  s_waitcnt vmcnt(3)
  s_barrier
  v_smfmac_f32_16x16x64_bf16 v[116:119], a[96:99], a[188:195], v12
  ds_read_b128 a[212:215], v19 offset:34560
  v_cvt_pk_bf16_f32 v60, v60, v61
  v_mfma_f32_16x16x32_bf16 v[64:67], a[60:63], a[164:167], v[64:67]
  buffer_load_dwordx4 v10, s[8:11], s29 offen offset:3840  lds
  v_mfma_f32_16x16x32_bf16 v[64:67], a[64:67], a[168:171], v[64:67]
  ds_read_b128 a[216:219], v20 offset:34560
  v_cvt_pk_bf16_f32 v61, v62, v63
  v_mfma_f32_16x16x32_bf16 v[64:67], a[68:71], a[172:175], v[64:67]
  ds_read_b128 a[220:223], v21 offset:34560
  v_mfma_f32_16x16x32_bf16 v[64:67], a[80:83], a[180:183], v[64:67]
  ds_read_b128 a[224:227], v25 offset:34560
  v_mfma_f32_16x16x32_bf16 v[64:67], a[84:87], a[184:187], v[64:67]
  ds_read_b128 v[176:179], v22 offset:23040
  v_mfma_f32_16x16x32_bf16 v[64:67], a[88:91], a[188:191], v[64:67]
  ds_read_b128 v[180:183], v23 offset:23040
  v_mfma_f32_16x16x32_bf16 v[64:67], a[104:107], a[252:255], v[64:67]
  ds_read_b128 v[184:187], v24 offset:23040
  v_mfma_f32_16x16x32_bf16 v[64:67], a[112:115], v[168:171], v[64:67]
  ds_read_b128 a[228:231], v19 offset:38400
  v_mfma_f32_16x16x32_bf16 v[64:67], a[120:123], v[172:175], v[64:67]
  s_waitcnt lgkmcnt(13)
  ds_read_b128 a[232:235], v20 offset:38400
  v_smfmac_f32_16x16x64_bf16 v[120:123], a[72:75], a[180:187], v12
  ds_read_b128 a[236:239], v21 offset:38400
  v_smfmac_f32_16x16x64_bf16 v[120:123], a[76:79], a[188:195], v12
  s_waitcnt lgkmcnt(13)
  ds_read_b128 a[240:243], v25 offset:38400
  v_smfmac_f32_16x16x64_bf16 v[120:123], a[92:95], a[196:203], v12
  ds_write_b32 v37, v60 offset:6144
  v_smfmac_f32_16x16x64_bf16 v[120:123], a[96:99], a[204:211], v12
  v_cvt_pk_bf16_f32 v64, v64, v65
  v_mfma_f32_16x16x32_bf16 v[68:71], a[60:63], a[180:183], v[68:71]
  s_waitcnt lgkmcnt(13)
  ds_write_b32 v37, v61 offset:6148
  v_mfma_f32_16x16x32_bf16 v[68:71], a[64:67], a[184:187], v[68:71]
  v_permlane32_swap_b32 v116, v118
  v_mfma_f32_16x16x32_bf16 v[68:71], a[68:71], a[188:191], v[68:71]
  v_permlane32_swap_b32 v117, v119
  v_mfma_f32_16x16x32_bf16 v[68:71], a[80:83], a[196:199], v[68:71]
  v_add_f32 v116, v116, v118
  v_add_f32 v117, v117, v119
  v_mfma_f32_16x16x32_bf16 v[68:71], a[84:87], a[200:203], v[68:71]
  v_cvt_pk_bf16_f32 v116, v116, v117
  v_cvt_pk_bf16_f32 v65, v66, v67
  v_mfma_f32_16x16x32_bf16 v[68:71], a[88:91], a[204:207], v[68:71]
  ds_write_b32 v38, v116 offset:9216
  v_mfma_f32_16x16x32_bf16 v[68:71], a[128:131], a[208:211], v[68:71]
  v_permlane32_swap_b32 v120, v122
  v_mfma_f32_16x16x32_bf16 v[68:71], a[100:103], a[252:255], v[68:71]
  s_waitcnt lgkmcnt(13)
  ds_write_b32 v37, v64 offset:9216
  v_mfma_f32_16x16x32_bf16 v[68:71], a[108:111], v[168:171], v[68:71]
  v_permlane32_swap_b32 v121, v123
  v_mfma_f32_16x16x32_bf16 v[68:71], a[116:119], v[172:175], v[68:71]
  s_waitcnt lgkmcnt(2)
  v_add_f32 v120, v120, v122
  v_add_f32 v121, v121, v123
  v_smfmac_f32_16x16x64_bf16 v[124:127], a[92:95], a[212:219], v12
  ds_write_b32 v37, v65 offset:9220
  v_smfmac_f32_16x16x64_bf16 v[124:127], a[96:99], a[220:227], v12
  v_cvt_pk_bf16_f32 v120, v120, v121
  v_mfma_f32_16x16x32_bf16 v[72:75], a[80:83], a[212:215], v[72:75]
  s_add_u32 m0, s25, 57600
  v_mfma_f32_16x16x32_bf16 v[72:75], a[84:87], a[216:219], v[72:75]
  s_add_u32 s29, s29, s96
  v_cvt_pk_bf16_f32 v68, v68, v69
  v_cvt_pk_bf16_f32 v69, v70, v71
  v_mfma_f32_16x16x32_bf16 v[72:75], a[88:91], a[220:223], v[72:75]
  ds_write_b32 v38, v120 offset:12288
  v_mfma_f32_16x16x32_bf16 v[72:75], a[104:107], v[176:179], v[72:75]
  buffer_load_dwordx4 v9, s[8:11], s29 offen  lds
  v_mfma_f32_16x16x32_bf16 v[72:75], a[112:115], v[180:183], v[72:75]
  ds_write_b32 v37, v68 offset:12288
  v_mfma_f32_16x16x32_bf16 v[72:75], a[120:123], v[184:187], v[72:75]
  v_permlane32_swap_b32 v124, v126
  v_smfmac_f32_16x16x64_bf16 v[128:131], a[72:75], a[212:219], v12
  ds_write_b32 v37, v69 offset:12292
  v_smfmac_f32_16x16x64_bf16 v[128:131], a[76:79], a[220:227], v12
  v_smfmac_f32_16x16x64_bf16 v[128:131], a[92:95], a[228:235], v12
  v_smfmac_f32_16x16x64_bf16 v[128:131], a[96:99], a[236:243], v12
  buffer_load_dwordx4 v10, s[8:11], s29 offen offset:3840  lds
  v_mfma_f32_16x16x32_bf16 v[76:79], a[60:63], a[212:215], v[76:79]
  v_permlane32_swap_b32 v125, v127
  v_mfma_f32_16x16x32_bf16 v[76:79], a[64:67], a[216:219], v[76:79]
  v_add_f32 v124, v124, v126
  v_add_f32 v125, v125, v127
  v_mfma_f32_16x16x32_bf16 v[76:79], a[68:71], a[220:223], v[76:79]
  v_cvt_pk_bf16_f32 v124, v124, v125
  v_cvt_pk_bf16_f32 v72, v72, v73
  v_mfma_f32_16x16x32_bf16 v[76:79], a[80:83], a[228:231], v[76:79]
  ds_write_b32 v38, v124 offset:15360
  v_mfma_f32_16x16x32_bf16 v[76:79], a[84:87], a[232:235], v[76:79]
  v_cvt_pk_bf16_f32 v73, v74, v75
  v_mfma_f32_16x16x32_bf16 v[76:79], a[88:91], a[236:239], v[76:79]
  ds_write_b32 v37, v72 offset:15360
  v_mfma_f32_16x16x32_bf16 v[76:79], a[128:131], a[240:243], v[76:79]
  v_permlane32_swap_b32 v128, v130
  v_mfma_f32_16x16x32_bf16 v[76:79], a[100:103], v[176:179], v[76:79]
  ds_write_b32 v37, v73 offset:15364
  v_mfma_f32_16x16x32_bf16 v[76:79], a[108:111], v[180:183], v[76:79]
  v_permlane32_swap_b32 v129, v131
  v_mfma_f32_16x16x32_bf16 v[76:79], a[116:119], v[184:187], v[76:79]
  v_add_f32 v128, v128, v130
  v_add_f32 v129, v129, v131
  v_smfmac_f32_16x16x64_bf16 v[132:135], a[52:55], a[212:219], v12
  v_cvt_pk_bf16_f32 v128, v128, v129
  v_smfmac_f32_16x16x64_bf16 v[132:135], a[56:59], a[220:227], v12
  ds_write_b32 v38, v128 offset:18432
  v_smfmac_f32_16x16x64_bf16 v[132:135], a[72:75], a[228:235], v12
  v_smfmac_f32_16x16x64_bf16 v[132:135], a[76:79], a[236:243], v12
  v_cvt_pk_bf16_f32 v76, v76, v77
  v_mfma_f32_16x16x32_bf16 v[80:83], a[40:43], a[212:215], v[80:83]
  v_cvt_pk_bf16_f32 v77, v78, v79
  v_mfma_f32_16x16x32_bf16 v[80:83], a[44:47], a[216:219], v[80:83]
  v_add_u32 v48, 1, v49
  v_mfma_f32_16x16x32_bf16 v[80:83], a[48:51], a[220:223], v[80:83]
  ds_write_b32 v37, v76 offset:18432
  v_mfma_f32_16x16x32_bf16 v[80:83], a[60:63], a[228:231], v[80:83]
  s_waitcnt vmcnt(3)
  v_mfma_f32_16x16x32_bf16 v[80:83], a[64:67], a[232:235], v[80:83]
  ds_write_b32 v45, v12 offset:32
  v_mfma_f32_16x16x32_bf16 v[80:83], a[68:71], a[236:239], v[80:83]
  ds_write_b32 v37, v77 offset:18436
  v_smfmac_f32_16x16x64_bf16 v[136:139], a[32:35], a[212:219], v12
  v_smfmac_f32_16x16x64_bf16 v[136:139], a[36:39], a[220:227], v12
  v_smfmac_f32_16x16x64_bf16 v[136:139], a[52:55], a[228:235], v12
  v_smfmac_f32_16x16x64_bf16 v[136:139], a[56:59], a[236:243], v12
  buffer_atomic_cmpswap v[48:49], v47, s[32:35], 0 offen sc0 sc1
  v_mfma_f32_16x16x32_bf16 v[84:87], a[0:3], a[196:199], 0
  ds_read_b32 v4, v46 offset:32
  v_mfma_f32_16x16x32_bf16 v[84:87], a[4:7], a[200:203], v[84:87]
  v_mfma_f32_16x16x32_bf16 v[84:87], a[8:11], a[204:207], v[84:87]
  v_mfma_f32_16x16x32_bf16 v[84:87], a[20:23], a[212:215], v[84:87]
  v_mfma_f32_16x16x32_bf16 v[84:87], a[24:27], a[216:219], v[84:87]
  v_mfma_f32_16x16x32_bf16 v[84:87], a[28:31], a[220:223], v[84:87]
  s_waitcnt lgkmcnt(0)
  v_cmp_eq_u32 vcc, 0, v4
  v_mfma_f32_16x16x32_bf16 v[84:87], a[40:43], a[228:231], v[84:87]
  s_cbranch_vccnz L_retry2
L_cont2:
  v_mfma_f32_16x16x32_bf16 v[84:87], a[44:47], a[232:235], v[84:87]
  ds_read_b128 v[156:159], v41 offset:0
  v_mfma_f32_16x16x32_bf16 v[84:87], a[48:51], a[236:239], v[84:87]
  ds_read_b128 v[160:163], v42 offset:0
  v_smfmac_f32_16x16x64_bf16 v[140:143], a[12:15], a[212:219], v12
  ds_read_b128 v[164:167], v43 offset:0
  v_smfmac_f32_16x16x64_bf16 v[140:143], a[16:19], a[220:227], v12
  ds_read_b128 a[244:247], v19 offset:42240
  v_smfmac_f32_16x16x64_bf16 v[140:143], a[32:35], a[228:235], v12
  ds_read_b128 a[248:251], v20 offset:42240
  v_smfmac_f32_16x16x64_bf16 v[140:143], a[36:39], a[236:243], v12
L_visit1:
  s_cbranch_execz L_back
  v_mfma_f32_16x16x32_bf16 v[88:91], a[0:3], a[212:215], 0
  ds_read_b128 v[192:195], v21 offset:42240
  v_mfma_f32_16x16x32_bf16 v[88:91], a[4:7], a[216:219], v[88:91]
  s_waitcnt lgkmcnt(3)
  ds_read_b128 v[196:199], v25 offset:42240
  v_mfma_f32_16x16x32_bf16 v[88:91], a[8:11], a[220:223], v[88:91]
  buffer_store_dwordx4 v[156:159], v44, s[16:19], s40 offen offset:0 sc1
  v_mfma_f32_16x16x32_bf16 v[88:91], a[20:23], a[228:231], v[88:91]
  ds_read_b128 v[188:191], v22 offset:30720
  v_mfma_f32_16x16x32_bf16 v[88:91], a[24:27], a[232:235], v[88:91]
  ds_read_b128 a[252:255], v23 offset:30720
  v_mfma_f32_16x16x32_bf16 v[88:91], a[28:31], a[236:239], v[88:91]
  s_waitcnt lgkmcnt(3)
  ds_read_b128 v[168:171], v24 offset:30720
  v_mfma_f32_16x16x32_bf16 v[88:91], a[40:43], a[244:247], v[88:91]
  buffer_store_dwordx4 v[160:163], v44, s[16:19], s40 offen offset:1024 sc1
  v_mfma_f32_16x16x32_bf16 v[88:91], a[44:47], a[248:251], v[88:91]
  ds_read_b128 v[224:227], v19 offset:46080
  v_mfma_f32_16x16x32_bf16 v[88:91], a[124:127], a[224:227], v[88:91]
  ds_read_b128 v[228:231], v20 offset:46080
  v_mfma_f32_16x16x32_bf16 v[88:91], a[48:51], v[192:195], v[88:91]
  ds_read_b128 v[200:203], v21 offset:46080
  v_smfmac_f32_16x16x64_bf16 v[132:135], a[92:95], a[244:251], v12
  s_waitcnt lgkmcnt(3)
  ds_read_b128 v[204:207], v25 offset:46080
  v_smfmac_f32_16x16x64_bf16 v[132:135], a[96:99], v[192:199], v12
  buffer_store_dwordx4 v[164:167], v44, s[16:19], s40 offen offset:2048 sc1
  v_mfma_f32_16x16x32_bf16 v[80:83], a[80:83], a[244:247], v[80:83]
  ds_read_b128 v[232:235], v19 offset:49920
  v_mfma_f32_16x16x32_bf16 v[80:83], a[84:87], a[248:251], v[80:83]
  ds_read_b128 v[236:239], v20 offset:49920
  v_mfma_f32_16x16x32_bf16 v[80:83], a[88:91], v[192:195], v[80:83]
  ds_read_b128 v[208:211], v21 offset:49920
  v_mfma_f32_16x16x32_bf16 v[80:83], a[104:107], v[188:191], v[80:83]
  ds_read_b128 v[212:215], v25 offset:49920
  v_mfma_f32_16x16x32_bf16 v[80:83], a[112:115], a[252:255], v[80:83]
  ds_read_b128 v[172:175], v22 offset:38400
  v_mfma_f32_16x16x32_bf16 v[80:83], a[120:123], v[168:171], v[80:83]
  v_permlane32_swap_b32 v132, v134
  v_smfmac_f32_16x16x64_bf16 v[136:139], a[72:75], a[244:251], v12
  ds_read_b128 v[176:179], v23 offset:38400
  v_smfmac_f32_16x16x64_bf16 v[136:139], a[76:79], v[192:199], v12
  s_waitcnt lgkmcnt(3)
  ds_read_b128 v[180:183], v24 offset:38400
  v_smfmac_f32_16x16x64_bf16 v[136:139], a[92:95], v[224:231], v12
  v_smfmac_f32_16x16x64_bf16 v[136:139], a[96:99], v[200:207], v12
  v_cvt_pk_bf16_f32 v80, v80, v81
  v_mfma_f32_16x16x32_bf16 v[84:87], a[60:63], a[244:247], v[84:87]
  v_permlane32_swap_b32 v133, v135
  v_mfma_f32_16x16x32_bf16 v[84:87], a[64:67], a[248:251], v[84:87]
  v_add_f32 v132, v132, v134
  v_add_f32 v133, v133, v135
  v_mfma_f32_16x16x32_bf16 v[84:87], a[68:71], v[192:195], v[84:87]
  v_cvt_pk_bf16_f32 v132, v132, v133
  v_cvt_pk_bf16_f32 v81, v82, v83
  v_mfma_f32_16x16x32_bf16 v[84:87], a[80:83], v[224:227], v[84:87]
  ds_write_b32 v38, v132 offset:21504
  v_mfma_f32_16x16x32_bf16 v[84:87], a[84:87], v[228:231], v[84:87]
  ds_write_b32 v37, v80 offset:21504
  v_mfma_f32_16x16x32_bf16 v[84:87], a[88:91], v[200:203], v[84:87]
  ds_write_b32 v37, v81 offset:21508
  v_mfma_f32_16x16x32_bf16 v[84:87], a[128:131], v[204:207], v[84:87]
  s_waitcnt vmcnt(4)
  v_permlane32_swap_b32 v136, v138
  v_mfma_f32_16x16x32_bf16 v[84:87], a[100:103], v[188:191], v[84:87]
  ds_write_b32 v45, v12 offset:48
  v_mfma_f32_16x16x32_bf16 v[84:87], a[108:111], a[252:255], v[84:87]
  v_permlane32_swap_b32 v137, v139
  v_mfma_f32_16x16x32_bf16 v[84:87], a[116:119], v[168:171], v[84:87]
  v_add_f32 v136, v136, v138
  v_add_f32 v137, v137, v139
  v_smfmac_f32_16x16x64_bf16 v[140:143], a[52:55], a[244:251], v12
  v_cvt_pk_bf16_f32 v136, v136, v137
  v_smfmac_f32_16x16x64_bf16 v[140:143], a[56:59], v[192:199], v12
  ds_write_b32 v38, v136 offset:24576
  v_smfmac_f32_16x16x64_bf16 v[140:143], a[72:75], v[224:231], v12
  v_smfmac_f32_16x16x64_bf16 v[140:143], a[76:79], v[200:207], v12
  ds_read_b32 v4, v46 offset:48
  v_cvt_pk_bf16_f32 v84, v84, v85
  v_smfmac_f32_16x16x64_bf16 v[140:143], a[92:95], v[232:239], v12
  s_waitcnt lgkmcnt(2)
  v_cvt_pk_bf16_f32 v85, v86, v87
  v_smfmac_f32_16x16x64_bf16 v[140:143], a[96:99], v[208:215], v12
  ds_write_b32 v37, v84 offset:24576
  v_mfma_f32_16x16x32_bf16 v[88:91], a[60:63], v[224:227], v[88:91]
  ds_write_b32 v37, v85 offset:24580
  v_mfma_f32_16x16x32_bf16 v[88:91], a[64:67], v[228:231], v[88:91]
  v_mfma_f32_16x16x32_bf16 v[88:91], a[68:71], v[200:203], v[88:91]
  s_waitcnt lgkmcnt(2)
  v_cmp_eq_u32 vcc, 0, v4
  v_mfma_f32_16x16x32_bf16 v[88:91], a[80:83], v[232:235], v[88:91]
  s_cbranch_vccnz L_retry3
L_cont3:
  v_mfma_f32_16x16x32_bf16 v[88:91], a[84:87], v[236:239], v[88:91]
  ds_read_b128 v[156:159], v41 offset:12288
  v_mfma_f32_16x16x32_bf16 v[88:91], a[88:91], v[208:211], v[88:91]
  ds_read_b128 v[160:163], v42 offset:12288
  v_mfma_f32_16x16x32_bf16 v[88:91], a[104:107], v[172:175], v[88:91]
  ds_read_b128 v[164:167], v43 offset:12288
  v_mfma_f32_16x16x32_bf16 v[88:91], a[112:115], v[176:179], v[88:91]
  ds_read_b128 v[240:243], v19 offset:53760
  v_mfma_f32_16x16x32_bf16 v[88:91], a[120:123], v[180:183], v[88:91]
  ds_read_b128 v[244:247], v20 offset:53760
  v_smfmac_f32_16x16x64_bf16 v[144:147], a[12:15], a[228:235], v12
  ds_read_b128 v[216:219], v21 offset:53760
  v_smfmac_f32_16x16x64_bf16 v[144:147], a[16:19], a[236:243], v12
  s_waitcnt vmcnt(3)
  v_cmp_eq_u32 s[12:13], v48, v49
  v_smfmac_f32_16x16x64_bf16 v[144:147], a[32:35], a[244:251], v12
  s_and_b32 s12, s12, s43
  s_add_u32 s12, s12, 1
  v_mov_b32 v7, s12
  v_smfmac_f32_16x16x64_bf16 v[144:147], a[36:39], v[192:199], v12
  s_waitcnt lgkmcnt(2)
  ds_read_b128 v[220:223], v25 offset:53760
  v_smfmac_f32_16x16x64_bf16 v[144:147], a[52:55], v[224:231], v12
  buffer_store_dwordx4 v[156:159], v44, s[16:19], s3 offen offset:0 sc1
  v_smfmac_f32_16x16x64_bf16 v[144:147], a[56:59], v[200:207], v12
  ds_read_b128 v[248:251], v19 offset:57600
  v_cvt_pk_bf16_f32 v88, v88, v89
  v_smfmac_f32_16x16x64_bf16 v[144:147], a[72:75], v[232:239], v12
  ds_read_b128 v[252:255], v20 offset:57600
  v_cvt_pk_bf16_f32 v89, v90, v91
  v_smfmac_f32_16x16x64_bf16 v[144:147], a[76:79], v[208:215], v12
  s_waitcnt lgkmcnt(3)
  ds_read_b128 a[132:135], v21 offset:57600
  v_smfmac_f32_16x16x64_bf16 v[144:147], a[92:95], v[240:247], v12
  buffer_store_dwordx4 v[160:163], v44, s[16:19], s3 offen offset:1024 sc1
  v_mfma_f32_16x16x32_bf16 v[92:95], a[0:3], a[228:231], 0
  ds_read_b128 a[136:139], v25 offset:57600
  v_mfma_f32_16x16x32_bf16 v[92:95], a[4:7], a[232:235], v[92:95]
  ds_read_b128 v[184:187], v22 offset:46080
  v_mfma_f32_16x16x32_bf16 v[92:95], a[8:11], a[236:239], v[92:95]
  ds_read_b128 v[188:191], v23 offset:46080
  v_mfma_f32_16x16x32_bf16 v[92:95], a[20:23], a[244:247], v[92:95]
  buffer_store_dwordx4 v[164:167], v44, s[16:19], s3 offen offset:2048 sc1
  v_mfma_f32_16x16x32_bf16 v[92:95], a[24:27], a[248:251], v[92:95]
  ds_read_b128 a[252:255], v24 offset:46080
  v_mfma_f32_16x16x32_bf16 v[92:95], a[28:31], v[192:195], v[92:95]
L_visit2:
  s_cbranch_execz L_back
  v_mfma_f32_16x16x32_bf16 v[92:95], a[40:43], v[224:227], v[92:95]
  ds_read_b128 a[148:151], v19 offset:61440
  v_mfma_f32_16x16x32_bf16 v[92:95], a[44:47], v[228:231], v[92:95]
  ds_read_b128 a[152:155], v20 offset:61440
  v_mfma_f32_16x16x32_bf16 v[92:95], a[48:51], v[200:203], v[92:95]
  ds_read_b128 a[140:143], v21 offset:61440
  v_mfma_f32_16x16x32_bf16 v[92:95], a[60:63], v[232:235], v[92:95]
  ds_read_b128 a[144:147], v25 offset:61440
  v_mfma_f32_16x16x32_bf16 v[92:95], a[64:67], v[236:239], v[92:95]
  v_permlane32_swap_b32 v140, v142
  v_mfma_f32_16x16x32_bf16 v[92:95], a[68:71], v[208:211], v[92:95]
  v_permlane32_swap_b32 v141, v143
  v_mfma_f32_16x16x32_bf16 v[92:95], a[80:83], v[240:243], v[92:95]
  v_add_f32 v140, v140, v142
  v_add_f32 v141, v141, v143
  v_mfma_f32_16x16x32_bf16 v[92:95], a[84:87], v[244:247], v[92:95]
  v_cvt_pk_bf16_f32 v140, v140, v141
  v_mfma_f32_16x16x32_bf16 v[92:95], a[88:91], v[216:219], v[92:95]
  s_waitcnt lgkmcnt(0)
  v_mfma_f32_16x16x32_bf16 v[92:95], a[128:131], v[220:223], v[92:95]
  ds_write_b32 v38, v140 offset:27648
  v_mfma_f32_16x16x32_bf16 v[92:95], a[100:103], v[172:175], v[92:95]
  ds_write_b32 v37, v88 offset:27648
  v_mfma_f32_16x16x32_bf16 v[92:95], a[108:111], v[176:179], v[92:95]
  ds_write_b32 v37, v89 offset:27652
  v_mfma_f32_16x16x32_bf16 v[92:95], a[116:119], v[180:183], v[92:95]
  ds_write_b32 v45, v7 offset:64
  v_smfmac_f32_16x16x64_bf16 v[144:147], a[96:99], v[216:223], v12
  v_smfmac_f32_16x16x64_bf16 v[148:151], a[12:15], a[244:251], v12
  v_smfmac_f32_16x16x64_bf16 v[148:151], a[16:19], v[192:199], v12
  v_smfmac_f32_16x16x64_bf16 v[148:151], a[32:35], v[224:231], v12
  v_smfmac_f32_16x16x64_bf16 v[148:151], a[36:39], v[200:207], v12
  v_smfmac_f32_16x16x64_bf16 v[148:151], a[52:55], v[232:239], v12
  ds_read_b32 v4, v46 offset:64
  v_cvt_pk_bf16_f32 v92, v92, v93
  v_smfmac_f32_16x16x64_bf16 v[148:151], a[56:59], v[208:215], v12
  v_cvt_pk_bf16_f32 v93, v94, v95
  v_smfmac_f32_16x16x64_bf16 v[148:151], a[72:75], v[240:247], v12
  ds_write_b32 v37, v92 offset:30720
  v_smfmac_f32_16x16x64_bf16 v[148:151], a[76:79], v[216:223], v12
  ds_write_b32 v37, v93 offset:30724
  v_smfmac_f32_16x16x64_bf16 v[148:151], a[92:95], v[248:255], v12
  v_smfmac_f32_16x16x64_bf16 v[148:151], a[96:99], a[132:139], v12
  s_waitcnt lgkmcnt(2)
  v_cmp_eq_u32 vcc, 0, v4
  v_mfma_f32_16x16x32_bf16 v[96:99], a[0:3], a[244:247], 0
  s_cbranch_vccnz L_retry4
L_cont4:
  v_readfirstlane_b32 s43, v4
  v_mfma_f32_16x16x32_bf16 v[96:99], a[4:7], a[248:251], v[96:99]
  ds_read_b128 v[156:159], v39 offset:24576
  v_mfma_f32_16x16x32_bf16 v[96:99], a[8:11], v[192:195], v[96:99]
  ds_read_b128 v[160:163], v39 offset:27648
  v_mfma_f32_16x16x32_bf16 v[96:99], a[20:23], v[224:227], v[96:99]
  v_permlane32_swap_b32 v144, v146
  v_mfma_f32_16x16x32_bf16 v[96:99], a[24:27], v[228:231], v[96:99]
  v_permlane32_swap_b32 v145, v147
  v_mfma_f32_16x16x32_bf16 v[96:99], a[28:31], v[200:203], v[96:99]
  v_add_f32 v144, v144, v146
  v_add_f32 v145, v145, v147
  v_mfma_f32_16x16x32_bf16 v[96:99], a[40:43], v[232:235], v[96:99]
  v_cvt_pk_bf16_f32 v144, v144, v145
  v_mfma_f32_16x16x32_bf16 v[96:99], a[44:47], v[236:239], v[96:99]
  ds_write_b32 v38, v144 offset:30720
  v_mfma_f32_16x16x32_bf16 v[96:99], a[48:51], v[208:211], v[96:99]
  ds_write_b32 v45, v12 offset:80
  v_mfma_f32_16x16x32_bf16 v[96:99], a[60:63], v[240:243], v[96:99]
  s_waitcnt lgkmcnt(2)
  v_permlane32_swap_b32 v148, v150
  v_mfma_f32_16x16x32_bf16 v[96:99], a[64:67], v[244:247], v[96:99]
  buffer_store_dwordx4 v[156:159], v40, s[16:19], s4 offen offset:0 sc1
  v_mfma_f32_16x16x32_bf16 v[96:99], a[68:71], v[216:219], v[96:99]
  v_permlane32_swap_b32 v149, v151
  v_mfma_f32_16x16x32_bf16 v[96:99], a[80:83], v[248:251], v[96:99]
  v_add_f32 v148, v148, v150
  v_add_f32 v149, v149, v151
  v_mfma_f32_16x16x32_bf16 v[96:99], a[84:87], v[252:255], v[96:99]
  v_cvt_pk_bf16_f32 v148, v148, v149
  v_mfma_f32_16x16x32_bf16 v[96:99], a[88:91], a[132:135], v[96:99]
  ds_read_b32 v4, v46 offset:80
  v_mfma_f32_16x16x32_bf16 v[96:99], a[124:127], v[196:199], v[96:99]
  buffer_store_dwordx4 v[160:163], v40, s[16:19], s5 offen offset:0 sc1
  v_mfma_f32_16x16x32_bf16 v[96:99], a[104:107], v[184:187], v[96:99]
  ds_write_b32 v38, v148 offset:33792
  v_mfma_f32_16x16x32_bf16 v[96:99], a[112:115], v[188:191], v[96:99]
  s_cmp_eq_u32 s43, 1
  v_mfma_f32_16x16x32_bf16 v[96:99], a[120:123], a[252:255], v[96:99]
  s_cbranch_scc1 L_short
  v_smfmac_f32_16x16x64_bf16 v[152:155], a[52:55], v[240:247], v12
  s_cmp_eq_u32 s42, 0
  s_waitcnt lgkmcnt(1)
  v_cmp_eq_u32 vcc, 0, v4
  v_smfmac_f32_16x16x64_bf16 v[152:155], a[56:59], v[216:223], v12
  s_cbranch_scc1 L_upper
  v_smfmac_f32_16x16x64_bf16 v[152:155], a[12:15], v[224:231], v12
  s_cbranch_vccnz L_retry5
L_cont5:
  v_smfmac_f32_16x16x64_bf16 v[152:155], a[16:19], v[200:207], v12
  ds_read_b128 v[164:167], v39 offset:30720
  v_cvt_pk_bf16_f32 v96, v96, v97
  v_smfmac_f32_16x16x64_bf16 v[152:155], a[32:35], v[232:239], v12
  v_cvt_pk_bf16_f32 v97, v98, v99
  v_smfmac_f32_16x16x64_bf16 v[152:155], a[36:39], v[208:215], v12
  ds_write_b32 v37, v96 offset:33792
  v_smfmac_f32_16x16x64_bf16 v[152:155], a[72:75], v[248:255], v12
  ds_write_b32 v37, v97 offset:33796
  v_smfmac_f32_16x16x64_bf16 v[152:155], a[76:79], a[132:139], v12
  v_smfmac_f32_16x16x64_bf16 v[152:155], a[92:95], a[148:155], v12
  v_smfmac_f32_16x16x64_bf16 v[152:155], a[96:99], a[140:147], v12
  v_mfma_f32_16x16x32_bf16 v[100:103], a[0:3], v[224:227], 0
  s_waitcnt lgkmcnt(1)
  v_mfma_f32_16x16x32_bf16 v[100:103], a[4:7], v[228:231], v[100:103]
  s_waitcnt lgkmcnt(0)
  s_barrier
  v_mfma_f32_16x16x32_bf16 v[100:103], a[8:11], v[200:203], v[100:103]
  buffer_store_dwordx4 v[164:167], v40, s[16:19], s6 offen offset:0 sc1
  v_mfma_f32_16x16x32_bf16 v[100:103], a[20:23], v[232:235], v[100:103]
  ds_read_b128 v[156:159], v39 offset:33792
  v_mfma_f32_16x16x32_bf16 v[100:103], a[24:27], v[236:239], v[100:103]
  v_permlane32_swap_b32 v152, v154
  v_mfma_f32_16x16x32_bf16 v[100:103], a[28:31], v[208:211], v[100:103]
  v_permlane32_swap_b32 v153, v155
  v_mfma_f32_16x16x32_bf16 v[100:103], a[40:43], v[240:243], v[100:103]
  v_add_f32 v152, v152, v154
  v_add_f32 v153, v153, v155
  v_mfma_f32_16x16x32_bf16 v[100:103], a[44:47], v[244:247], v[100:103]
  v_cvt_pk_bf16_f32 v152, v152, v153
  v_mfma_f32_16x16x32_bf16 v[100:103], a[48:51], v[216:219], v[100:103]
  ds_write_b32 v38, v152 offset:36864
  v_mfma_f32_16x16x32_bf16 v[100:103], a[60:63], v[248:251], v[100:103]
  v_mfma_f32_16x16x32_bf16 v[100:103], a[64:67], v[252:255], v[100:103]
  s_waitcnt lgkmcnt(1)
  v_mfma_f32_16x16x32_bf16 v[100:103], a[68:71], a[132:135], v[100:103]
  buffer_store_dwordx4 v[156:159], v40, s[16:19], s7 offen offset:0 sc1
  v_mfma_f32_16x16x32_bf16 v[100:103], a[80:83], a[148:151], v[100:103]
  v_mfma_f32_16x16x32_bf16 v[100:103], a[84:87], a[152:155], v[100:103]
  v_mfma_f32_16x16x32_bf16 v[100:103], a[88:91], a[140:143], v[100:103]
  v_mfma_f32_16x16x32_bf16 v[100:103], a[100:103], v[184:187], v[100:103]
  v_mfma_f32_16x16x32_bf16 v[100:103], a[108:111], v[188:191], v[100:103]
  v_mfma_f32_16x16x32_bf16 v[100:103], a[116:119], a[252:255], v[100:103]
  v_mfma_f32_16x16x32_bf16 v[100:103], a[128:131], a[144:147], v[100:103]
  s_nop 7
  v_cvt_pk_bf16_f32 v100, v100, v101
  v_cvt_pk_bf16_f32 v101, v102, v103
  ds_write_b64 v37, v[100:101] offset:36864
  s_waitcnt lgkmcnt(0)
  s_barrier
  ds_read_b128 v[160:163], v39 offset:36864
  s_waitcnt lgkmcnt(0)
  buffer_store_dwordx4 v[160:163], v40, s[16:19], s0 offen offset:0 sc1
L_fin:
  s_endpgm
L_visit3:
  s_branch L_back
L_short:
  s_waitcnt lgkmcnt(1)
  v_cmp_eq_u32 vcc, 0, v4
  s_nop 4
  s_cbranch_vccnz L_retry5s
L_cont5s:
  ds_read_b128 v[164:167], v39 offset:30720
  s_nop 1
  v_cvt_pk_bf16_f32 v96, v96, v97
  v_cvt_pk_bf16_f32 v97, v98, v99
  ds_write_b64 v37, v[96:97] offset:33792
  s_waitcnt lgkmcnt(1)
  buffer_store_dwordx4 v[164:167], v40, s[16:19], s6 offen offset:0 sc1
  s_waitcnt lgkmcnt(0)
  s_barrier
  ds_read_b128 v[156:159], v39 offset:33792
  s_waitcnt lgkmcnt(0)
  buffer_store_dwordx4 v[156:159], v40, s[16:19], s7 offen offset:0 sc1
  s_endpgm
L_retry5s:
  ds_read_b32 v4, v46 offset:80
  s_waitcnt lgkmcnt(0)
  v_cmp_eq_u32 vcc, 0, v4
  s_nop 4
  s_cbranch_vccnz L_retry5s
  s_branch L_cont5s
L_upper:
  v_smfmac_f32_16x16x64_bf16 v[152:155], a[92:95], a[148:155], v12
  s_cbranch_vccnz L_retry5u
L_cont5u:
  v_smfmac_f32_16x16x64_bf16 v[152:155], a[96:99], a[140:147], v12
  ds_read_b128 v[164:167], v39 offset:30720
  v_cvt_pk_bf16_f32 v96, v96, v97
  v_smfmac_f32_16x16x64_bf16 v[152:155], a[72:75], v[248:255], v12
  ds_read_b128 v[168:171], v22 offset:49920
  v_cvt_pk_bf16_f32 v97, v98, v99
  v_smfmac_f32_16x16x64_bf16 v[152:155], a[76:79], a[132:139], v12
  ds_read_b128 v[172:175], v23 offset:49920
  v_smfmac_f32_16x16x64_bf16 v[152:155], a[32:35], v[232:239], v12
  ds_read_b128 v[176:179], v24 offset:49920
  v_smfmac_f32_16x16x64_bf16 v[152:155], a[36:39], v[208:215], v12
  ds_write_b32 v37, v96 offset:33792
  v_smfmac_f32_16x16x64_bf16 v[152:155], a[12:15], v[224:231], v12
  ds_write_b32 v37, v97 offset:33796
  v_smfmac_f32_16x16x64_bf16 v[152:155], a[16:19], v[200:207], v12
  v_mfma_f32_16x16x32_bf16 v[100:103], a[80:83], a[148:151], 0
  s_waitcnt lgkmcnt(3)
  v_mfma_f32_16x16x32_bf16 v[100:103], a[84:87], a[152:155], v[100:103]
  buffer_store_dwordx4 v[164:167], v40, s[16:19], s6 offen offset:0 sc1
  v_mfma_f32_16x16x32_bf16 v[100:103], a[88:91], a[140:143], v[100:103]
  v_mfma_f32_16x16x32_bf16 v[100:103], a[60:63], v[248:251], v[100:103]
  s_waitcnt lgkmcnt(0)
  s_barrier
  v_mfma_f32_16x16x32_bf16 v[100:103], a[64:67], v[252:255], v[100:103]
  ds_read_b128 v[156:159], v39 offset:33792
  v_mfma_f32_16x16x32_bf16 v[100:103], a[68:71], a[132:135], v[100:103]
  v_permlane32_swap_b32 v152, v154
  v_mfma_f32_16x16x32_bf16 v[100:103], a[40:43], v[240:243], v[100:103]
  v_permlane32_swap_b32 v153, v155
  v_mfma_f32_16x16x32_bf16 v[100:103], a[44:47], v[244:247], v[100:103]
  v_add_f32 v152, v152, v154
  v_add_f32 v153, v153, v155
  v_mfma_f32_16x16x32_bf16 v[100:103], a[48:51], v[216:219], v[100:103]
  v_cvt_pk_bf16_f32 v152, v152, v153
  v_mfma_f32_16x16x32_bf16 v[100:103], a[20:23], v[232:235], v[100:103]
  ds_write_b32 v38, v152 offset:36864
  v_mfma_f32_16x16x32_bf16 v[100:103], a[24:27], v[236:239], v[100:103]
  v_mfma_f32_16x16x32_bf16 v[100:103], a[28:31], v[208:211], v[100:103]
  s_waitcnt lgkmcnt(1)
  v_mfma_f32_16x16x32_bf16 v[100:103], a[0:3], v[224:227], v[100:103]
  buffer_store_dwordx4 v[156:159], v40, s[16:19], s7 offen offset:0 sc1
  v_mfma_f32_16x16x32_bf16 v[100:103], a[4:7], v[228:231], v[100:103]
  v_mfma_f32_16x16x32_bf16 v[100:103], a[8:11], v[200:203], v[100:103]
  v_mfma_f32_16x16x32_bf16 v[100:103], a[104:107], v[168:171], v[100:103]
  v_mfma_f32_16x16x32_bf16 v[100:103], a[112:115], v[172:175], v[100:103]
  v_mfma_f32_16x16x32_bf16 v[100:103], a[120:123], v[176:179], v[100:103]
  v_mfma_f32_16x16x32_bf16 v[100:103], a[124:127], v[204:207], v[100:103]
  s_nop 7
  v_cvt_pk_bf16_f32 v100, v100, v101
  v_cvt_pk_bf16_f32 v101, v102, v103
  ds_write_b64 v37, v[100:101] offset:36864
  s_waitcnt lgkmcnt(0)
  s_barrier
  ds_read_b128 v[160:163], v39 offset:36864
  s_waitcnt lgkmcnt(0)
  buffer_store_dwordx4 v[160:163], v40, s[16:19], s0 offen offset:0 sc1
  s_endpgm
L_retry5u:
  ds_read_b32 v4, v46 offset:80
  s_waitcnt lgkmcnt(0)
  v_cmp_eq_u32 vcc, 0, v4
  s_nop 4
  s_cbranch_vccnz L_retry5u
  s_branch L_cont5u
L_retry1:
  ds_read_b32 v4, v46 offset:16
  s_waitcnt lgkmcnt(0)
  v_cmp_eq_u32 vcc, 0, v4
  s_nop 4
  s_cbranch_vccnz L_retry1
  s_branch L_cont1
L_retry2:
  ds_read_b32 v4, v46 offset:32
  s_waitcnt lgkmcnt(0)
  v_cmp_eq_u32 vcc, 0, v4
  s_nop 4
  s_cbranch_vccnz L_retry2
  s_branch L_cont2
L_retry3:
  ds_read_b32 v4, v46 offset:48
  s_waitcnt lgkmcnt(0)
  v_cmp_eq_u32 vcc, 0, v4
  s_nop 4
  s_cbranch_vccnz L_retry3
  s_branch L_cont3
L_retry4:
  ds_read_b32 v4, v46 offset:64
  s_waitcnt lgkmcnt(0)
  v_cmp_eq_u32 vcc, 0, v4
  s_nop 4
  s_cbranch_vccnz L_retry4
  s_branch L_cont4
L_retry5:
  ds_read_b32 v4, v46 offset:80
  s_waitcnt lgkmcnt(0)
  v_cmp_eq_u32 vcc, 0, v4
  s_nop 4
  s_cbranch_vccnz L_retry5
  s_branch L_cont5
L_end:
  s_endpgm
.p2align 12
L_pad:
.section .rodata,"a"
.p2align 6
.amdhsa_kernel standalone__grouped__vision_kernel
  .amdhsa_next_free_vgpr 512
  .amdhsa_next_free_sgpr 102
  .amdhsa_accum_offset 256
  .amdhsa_group_segment_fixed_size 0
  .amdhsa_kernarg_size 40
  .amdhsa_user_sgpr_count 2
  .amdhsa_user_sgpr_kernarg_segment_ptr 1
  .amdhsa_system_sgpr_workgroup_id_x 1
  .amdhsa_float_denorm_mode_32 3
.end_amdhsa_kernel
```
